```python
import torch

def _softmax(x, axis=-1):
    return torch.softmax(x, dim=axis)

def _gelu(x):
    return torch.nn.functional.gelu(x, approximate='tanh')

def _silu(x):
    return torch.nn.functional.silu(x)

def _sigmoid(x):
    return torch.sigmoid(x)

def _layernorm(x, axis=-1, eps=1e-05):
    m = x.mean(dim=axis, keepdim=True)
    v = x.var(dim=axis, keepdim=True, unbiased=False)
    return (x - m) / torch.sqrt(v + eps)

def _scatter_add(tgt, idx, src, axis=0):
    return tgt.clone().index_add_(axis, idx, src)

def _segment_sum(src, seg, n):
    out = torch.zeros((n,) + src.shape[1:], dtype=src.dtype)
    return out.index_add_(0, seg, src)

def _pad(x, pw):
    flat = tuple((v for pair in reversed(pw) for v in pair))
    return torch.nn.functional.pad(x, flat)
kernel_name = 'gather_scatter__tensor_product_equiv_equiformer__graph'

def setup_inputs():

    _w = lambda a: (lambda t: t.to(torch.bfloat16) if t.is_floating_point() else t)(torch.as_tensor(a))
    N, deg, C, De = (10000, 16, 128, max(0, 1))
    E = N * deg
    src = (lambda lo, hi, *s: torch.randint(lo, hi, s))(0, N, E).to(torch.int64)
    dst = (lambda lo, hi, *s: torch.randint(lo, hi, s))(0, N, E).to(torch.int64)
    rvec = (lambda *s: torch.randn(*s, dtype=torch.bfloat16) * 0.05)(E, 3).to(float)
    rn = (torch.linalg.norm(rvec, dim=-1, keepdim=True) + 1e-06).to(float)
    rhat = (rvec / rn).to(float)
    eps = torch.zeros((3, 3, 3), dtype=float)
    eps[0, 1, 2] = eps[1, 2, 0] = eps[2, 0, 1] = 1.0
    eps[0, 2, 1] = eps[2, 1, 0] = eps[1, 0, 2] = -1.0
    return {'x': _w((lambda *s: torch.randn(*s, dtype=torch.bfloat16) * 0.4)(N, 4 * C).to(float)), 'rhat': _w(rhat), 'e_attr': _w((lambda *s: torch.randn(*s, dtype=torch.bfloat16) * 0.4)(E, De).to(float)), 'src': _w(src), 'dst': _w(dst), 'w_rad': _w((lambda *s: torch.randn(*s, dtype=torch.bfloat16) * 0.4)(De, 5 * C).to(float)), 'w_si0': _w((lambda *s: torch.randn(*s, dtype=torch.bfloat16) * 0.4)(2 * C, C).to(float)), 'w_si1': _w((lambda *s: torch.randn(*s, dtype=torch.bfloat16) * 0.05)(3 * C, C).to(float)), 'cg_eps': _w(eps)}

def reference(x, rhat, e_attr, src, dst, w_rad, w_si0, w_si1, cg_eps):
    N = x.shape[0]
    C = w_si0.shape[1]
    E = rhat.shape[0]
    x0 = x[:, :C].clone()
    x1 = x[:, C:].reshape(N, 3, C)
    R = (e_attr @ w_rad).reshape(E, 5, C)
    f0 = x0[src]
    f1 = x1[src]
    Y1 = rhat
    p00_0 = f0 * R[:, 0, :]
    p11_0 = torch.einsum('ejc,ej->ec', f1, Y1) * R[:, 1, :]
    p01_1 = torch.einsum('ec,ej->ejc', f0, Y1) * R[:, 2, :][:, None, :]
    p10_1 = f1 * R[:, 3, :][:, None, :]
    p11_1 = torch.einsum('ijk,ekc,ej->eic', cg_eps, f1, Y1) * R[:, 4, :][:, None, :]
    m0 = torch.concatenate([p00_0, p11_0], axis=-1) @ w_si0
    m1 = torch.einsum('ejp,pc->ejc', torch.concatenate([p01_1, p10_1, p11_1], axis=-1), w_si1)
    agg0 = _segment_sum(m0, dst, N)
    agg1 = _segment_sum(m1.reshape(E, 3 * C), dst, N).reshape(N, 3, C)
    gate = _sigmoid(agg0)
    out1 = agg1 * gate[:, None, :]
    return torch.concatenate([agg0, out1.reshape(N, 3 * C)], axis=-1)
```

```asm
; @launch grid=(256,1,1) block=(1024,1,1) lds=161920
.amdgcn_target "amdgcn-amd-amdhsa--gfx950"
.text
.globl gather_scatter__tensor_product_equiv_equiformer__graph_kernel
.p2align 8
.type gather_scatter__tensor_product_equiv_equiformer__graph_kernel,@function
gather_scatter__tensor_product_equiv_equiformer__graph_kernel:

  s_cmp_ge_u32 s2, 256
  s_cbranch_scc1 M_end
  s_load_dwordx16 s[4:19], s[0:1], 0
  s_load_dwordx8 s[20:27], s[0:1], 64

  s_memrealtime s[82:83]
  v_and_b32 v1, 63, v0
  v_lshrrev_b32 v2, 6, v0
  v_lshlrev_b32 v3, 2, v0
  v_readfirstlane_b32 s3, v2
  s_cmp_eq_u32 s3, 15
  s_cbranch_scc0 M_nocpf
  s_getpc_b64 s[90:91]
M_pc0:
  s_sub_u32 s90, s90, M_pc0-gather_scatter__tensor_product_equiv_equiformer__graph_kernel
  s_subb_u32 s91, s91, 0
  v_lshlrev_b32 v4, 7, v1
  v_cmp_gt_u32 vcc, M_last-gather_scatter__tensor_product_equiv_equiformer__graph_kernel, v4
  s_and_saveexec_b64 s[44:45], vcc
  global_load_dword v127, v4, s[90:91]
  s_mov_b64 exec, s[44:45]
  v_add_u32 v4, 8192, v4
  v_cmp_gt_u32 vcc, M_last-gather_scatter__tensor_product_equiv_equiformer__graph_kernel, v4
  s_and_saveexec_b64 s[44:45], vcc
  s_cbranch_execz M_cpf2
  global_load_dword v127, v4, s[90:91]
M_cpf2:
  s_mov_b64 exec, s[44:45]
M_nocpf:

  v_add_u32 v5, 144704, v3
  v_mov_b32 v4, 0
  v_cmp_gt_u32 vcc, 336, v0
  s_and_saveexec_b64 s[44:45], vcc
  s_cbranch_execz M_nz
  ds_write_b32 v5, v4
M_nz:
  s_mov_b64 exec, s[44:45]
  v_add_u32 v5, 161664, v3
  v_cmp_gt_u32 vcc, 64, v0
  s_and_saveexec_b64 s[44:45], vcc
  s_cbranch_execz M_npt
  ds_write_b32 v5, v0
M_npt:
  s_mov_b64 exec, s[44:45]
  v_lshlrev_b32 v5, 4, v0
  v_add_u32 v5, 113920, v5
  v_mov_b32 v6, 0
  v_mov_b32 v7, 2147418112
  v_mov_b32 v8, 0
  v_mov_b32 v9, 2147418112
  ds_write_b128 v5, v[6:9]
  v_cmp_gt_u32 vcc, 900, v0
  s_and_saveexec_b64 s[44:45], vcc
  s_cbranch_execz M_np
  ds_write_b128 v5, v[6:9] offset:16384
M_np:
  s_mov_b64 exec, s[44:45]
  s_mul_i32 s80, s2, 625
  s_add_u32 s81, s80, 640
  s_add_u32 s80, s80, 15
  s_lshr_b32 s80, s80, 4
  s_lshr_b32 s81, s81, 4
  s_sub_u32 s81, s81, s80
  s_cmp_lt_u32 s2, 250
  s_cselect_b32 s54, 1, 0
  s_cmp_lt_u32 s3, 5
  s_cselect_b32 s54, s54, 0
  s_mul_i32 s40, s2, 320
  v_add_u32 v2, s40, v0
  v_lshlrev_b32 v3, 3, v2
  v_lshlrev_b32 v4, 2, v2
  v_mul_u32_u24 v5, 12, v2
  s_cmp_eq_u32 s54, 0
  s_waitcnt lgkmcnt(0)
  s_cbranch_scc1 G_noedge
  global_load_dwordx2 v[56:57], v3, s[12:13] nt
  global_load_dwordx2 v[58:59], v3, s[10:11] nt
  global_load_dword v60, v4, s[8:9] nt
  global_load_dwordx3 v[62:64], v5, s[6:7] nt
G_noedge:
  s_mov_b32 s36, s26
  s_mov_b32 s37, s27
  s_mov_b32 s38, 4718592
  s_mov_b32 s39, 0x20000
  s_mov_b32 s28, s4
  s_mov_b32 s29, s5
  s_mov_b32 s30, 10240000
  s_mov_b32 s31, 0x20000
  s_mov_b32 s32, s22
  s_mov_b32 s33, s23
  s_mov_b32 s34, 10240000
  s_mov_b32 s35, 0x20000

  s_cmp_ge_u32 s3, 8
  s_cbranch_scc1 M_proj

  s_or_b32 s82, s82, 1
  s_xor_b32 s40, s3, 6
  s_or_b32 s40, s2, s40
  s_cmp_eq_u32 s40, 0
  s_cbranch_scc0 G_nopub
  v_mov_b32 v2, s82
  v_mov_b32 v3, 0
  s_mov_b64 exec, 1
  global_store_dword v3, v2, s[24:25] sc1
  s_mov_b64 exec, -1
G_nopub:
  v_mov_b32 v9, 0
  s_cmp_eq_u32 s3, 6
  s_cbranch_scc0 G_np1
  global_load_dword v8, v9, s[24:25] sc1
G_np1:
  s_cmp_eq_u32 s3, 7
  s_cbranch_scc0 G_nowr
  v_lshlrev_b32 v2, 4, v1
  global_load_dwordx4 v[56:59], v2, s[14:15]
  s_bfm_b64 exec, 16, 0
  global_load_dwordx4 v[60:63], v2, s[14:15] offset:1024
  s_mov_b64 exec, -1
G_nowr:
  s_barrier

  v_and_b32 v3, 15, v1
  v_lshrrev_b32 v4, 4, v1
  v_lshl_add_u32 v26, v3, 3, v4
  v_lshlrev_b32 v26, 1, v26
  v_add_u32 v26, 157312, v26
  v_mov_b32 v28, 0
  v_mov_b32 v29, 0
  v_mov_b32 v30, 0
  v_mov_b32 v31, 0
  v_mov_b32 v32, 0
  v_mov_b32 v33, 0
  v_mov_b32 v34, 0
  v_mov_b32 v35, 0
  v_mov_b32 v36, 0
  v_mov_b32 v37, 0

  v_lshlrev_b32 v14, 4, v3
  v_lshlrev_b32 v15, 4, v4
  v_and_b32 v6, 2, v1
  v_lshl_add_u32 v15, v6, 2, v15
  v_lshlrev_b32 v25, 2, v1
  v_and_b32 v6, 1, v1
  v_lshlrev_b32 v6, 1, v6
  v_add_u32 v7, 1, v6
  v_lshl_or_b32 v6, v7, 8, v6
  v_or_b32 v7, 0x0c0c0000, v6
  v_lshlrev_b32 v6, 16, v6
  v_or_b32 v6, 0x0c0c, v6
  v_bfe_u32 v11, v1, 2, 2
  v_mov_b32 v16, 0x0c0c0c0c
  v_mov_b32 v17, 0x0c0c0c0c
  v_cmp_eq_u32 vcc, 0, v11
  v_cmp_eq_u32 s[78:79], 1, v11
  s_nop 1
  v_cndmask_b32 v16, v16, v7, vcc
  v_cndmask_b32 v16, v16, v6, s[78:79]
  v_cmp_eq_u32 vcc, 2, v11
  v_cmp_eq_u32 s[78:79], 3, v11
  s_nop 1
  v_cndmask_b32 v17, v17, v7, vcc
  v_cndmask_b32 v17, v17, v6, s[78:79]
  v_mov_b32 v18, 0
  v_mov_b32 v19, 0
  v_mov_b32 v20, 0
  v_mov_b32 v21, 0
  v_mov_b32 v22, 0
  v_mov_b32 v23, 0
  v_mov_b32 v27, 1
  s_mul_i32 s63, s3, 2848
  s_mov_b32 s56, 109951163
  v_mov_b32 v4, 1
  v_mov_b32 v5, 145024
  s_cmp_eq_u32 s3, 6
  s_cbranch_scc0 G_nonce_done
  s_mov_b32 s83, 0
  s_cmp_eq_u32 s54, 0
  s_cbranch_scc1 G_nonce_w0
  s_waitcnt vmcnt(4)
  s_branch G_nonce_chk
G_nonce_w0:
  s_waitcnt vmcnt(0)
G_nonce_chk:
  v_readfirstlane_b32 s41, v8
  s_nop 0
  s_sub_u32 s42, s82, s41
  s_cmp_lt_i32 s42, 3000
  s_cselect_b32 s42, s41, 0
  s_cmp_lg_u32 s42, 0
  s_cbranch_scc1 G_nonce_got
  s_add_u32 s83, s83, 1
  s_cmp_ge_u32 s83, 16384
  s_cbranch_scc1 G_nonce_got
  global_load_dword v8, v9, s[24:25] sc1
  s_waitcnt vmcnt(0)
  s_branch G_nonce_chk
G_nonce_got:
  v_mov_b32 v8, s42
  v_mov_b32 v9, 144988
  ds_write_b32 v9, v8
G_nonce_done:
  s_cmp_eq_u32 s3, 7
  s_cbranch_scc0 G_nowr2
  v_lshlrev_b32 v2, 4, v1
  v_add_u32 v2, 157312, v2
  s_waitcnt vmcnt(0)
  ds_write_b128 v2, v[56:59]
  s_bfm_b64 exec, 16, 0
  ds_write_b128 v2, v[60:63] offset:1024
  s_mov_b64 exec, -1
G_nowr2:
  s_cmp_eq_u32 s54, 0
  s_cbranch_scc1 G_norank
  s_waitcnt vmcnt(3)
  v_mul_hi_u32 v74, v56, s56
  v_mul_u32_u24 v75, 625, v74
  v_and_b32 v76, 7, v74
  v_lshrrev_b32 v74, 3, v74
  v_lshl_or_b32 v74, v76, 5, v74
  v_lshl_add_u32 v76, v74, 2, v5
  v_add_u32 v75, 15, v75
  ds_add_rtn_u32 v77, v76, v4
  v_lshrrev_b32 v75, 4, v75
  v_sub_u32 v75, v56, v75
  v_mul_hi_u32 v90, v57, s56
  v_mul_u32_u24 v91, 625, v90
  v_and_b32 v92, 7, v90
  v_lshrrev_b32 v90, 3, v90
  v_lshl_or_b32 v90, v92, 5, v90
  v_lshl_add_u32 v92, v90, 2, v5
  v_add_u32 v91, 15, v91
  ds_add_rtn_u32 v93, v92, v4
  v_lshrrev_b32 v91, 4, v91
  v_sub_u32 v91, v57, v91
  v_mov_b32 v6, 144984
  s_waitcnt lgkmcnt(0)
  s_mov_b64 exec, 1
  ds_add_u32 v6, v4 offset:0
  s_mov_b64 exec, -1
  s_waitcnt vmcnt(0)
  v_lshlrev_b32 v68, 16, v60
  v_and_b32 v84, 0xffff0000, v60
  v_lshlrev_b32 v69, 16, v62
  v_and_b32 v70, 0xffff0000, v62
  v_lshlrev_b32 v71, 16, v63
  v_and_b32 v85, 0xffff0000, v63
  v_lshlrev_b32 v86, 16, v64
  v_and_b32 v87, 0xffff0000, v64
  v_mul_f32 v69, v68, v69
  v_mul_f32 v70, v68, v70
  v_mul_f32 v71, v68, v71
  v_lshl_or_b32 v81, v58, 10, v75
  v_cvt_pk_bf16_f32 v80, v68, v69
  v_cvt_pk_bf16_f32 v82, v70, v71
  v_mul_f32 v85, v84, v85
  v_mul_f32 v86, v84, v86
  v_mul_f32 v87, v84, v87
  v_lshl_or_b32 v97, v59, 10, v91
  v_cvt_pk_bf16_f32 v96, v84, v85
  v_cvt_pk_bf16_f32 v98, v86, v87
  s_branch G_s1pre
G_norank:
  v_mov_b32 v6, 144984
  s_waitcnt lgkmcnt(0)
  s_mov_b64 exec, 1
  ds_add_u32 v6, v4 offset:0
  s_mov_b64 exec, -1
G_s1pre:
  v_lshlrev_b32 v7, 4, v1
  v_add_u32 v7, 145024, v7
G_s1:
  ds_read_b32 v9, v6 offset:0
  s_waitcnt lgkmcnt(0)
  v_readfirstlane_b32 s42, v9
  s_nop 0
  s_cmp_lt_u32 s42, 8
  s_cbranch_scc1 G_s1
  ds_read_b128 v[100:103], v7
  ds_read_b32 v2, v6 offset:4
  s_lshl_b32 s41, s3, 5
  v_and_b32 v8, 31, v1
  v_add_u32 v8, s41, v8
  v_lshl_add_u32 v9, v8, 2, v5
  ds_read_b32 v110, v9
  s_waitcnt lgkmcnt(1)
  v_readfirstlane_b32 s82, v2
  v_add_u32 v105, v100, v101
  v_add_u32 v106, v105, v102
  v_add_u32 v108, v106, v103
  v_mov_b32 v109, v108
  s_cmp_eq_u32 s82, 0
  s_cbranch_scc1 G_setovf2
  s_cmp_ge_u32 s2, 250
  s_cbranch_scc1 G_consume
  v_add_u32_dpp v109, v109, v109 row_shr:1 row_mask:0xf bank_mask:0xf bound_ctrl:0
  s_nop 1
  v_add_u32_dpp v109, v109, v109 row_shr:2 row_mask:0xf bank_mask:0xf bound_ctrl:0
  s_nop 1
  v_add_u32_dpp v109, v109, v109 row_shr:4 row_mask:0xf bank_mask:0xf bound_ctrl:0
  s_nop 1
  v_add_u32_dpp v109, v109, v109 row_shr:8 row_mask:0xf bank_mask:0xf bound_ctrl:0
  s_nop 1
  v_add_u32_dpp v109, v109, v109 row_bcast:15 row_mask:0xa bank_mask:0xf
  s_nop 1
  v_add_u32_dpp v109, v109, v109 row_bcast:31 row_mask:0xc bank_mask:0xf
  v_mov_b32 v83, v2
  v_mov_b32 v99, v2
  v_sub_u32 v104, v109, v108
  v_add_u32 v107, v104, v106
  v_add_u32 v106, v104, v105
  v_add_u32 v105, v104, v100
  ds_write_b128 v7, v[104:107] offset:1024
  ds_read_b32 v111, v9 offset:1024
  v_mov_b32 v7, 147072
  s_cmp_eq_u32 s54, 0
  s_cbranch_scc1 G_nostage
  ds_read_b32 v78, v76 offset:1024
  ds_read_b32 v94, v92 offset:1024
  s_waitcnt lgkmcnt(0)
  v_add_u32 v78, v78, v77
  v_add_u32 v94, v94, v93
  v_lshl_add_u32 v78, v78, 4, v7
  v_lshl_add_u32 v94, v94, 4, v7
  ds_write_b128 v78, v[80:83]
  ds_write_b128 v94, v[96:99]
G_nostage:
  s_lshl_b32 s40, s2, 11
  s_add_u32 s40, s40, 4194304
  v_lshlrev_b32 v8, 3, v8
  v_add_u32 v8, s40, v8
  v_lshlrev_b32 v56, 4, v0
  v_add_u32 v57, v7, v56
  s_mul_i32 s40, s2, 10240
  v_add_u32 v56, s40, v56
  s_waitcnt lgkmcnt(0)
  v_lshl_or_b32 v110, v110, 16, v111
  v_mov_b32 v111, v2
  s_mov_b64 exec, 1
  ds_add_u32 v6, v4 offset:24
  s_mov_b64 exec, -1
  s_bfm_b64 exec, 32, 0
  buffer_store_dwordx2 v[110:111], v8, s[36:39], 0 offen sc1
  s_mov_b64 exec, -1
G_s1b:
  ds_read_b32 v9, v6 offset:24
  s_waitcnt lgkmcnt(0)
  v_readfirstlane_b32 s42, v9
  s_nop 0
  s_cmp_lt_u32 s42, 8
  s_cbranch_scc1 G_s1b
  ds_read_b128 v[60:63], v57
  s_cmp_ge_u32 s3, 6
  s_cbranch_scc0 G_one
  ds_read_b128 v[64:67], v57 offset:2048
  s_waitcnt lgkmcnt(0)
  buffer_store_dwordx4 v[64:67], v56, s[36:39], 0 offen offset:2048 sc1
G_one:
  s_waitcnt lgkmcnt(0)
  buffer_store_dwordx4 v[60:63], v56, s[36:39], 0 offen sc1
G_consume:
  s_and_b32 s40, s2, 7
  s_lshl_b32 s40, s40, 5
  s_lshr_b32 s41, s2, 3
  s_or_b32 s40, s40, s41
  s_lshl_b32 s40, s40, 3
  s_add_u32 s40, s40, 4194304
  s_lshl_b32 s41, s3, 5
  v_lshrrev_b32 v2, 3, v1
  v_add_u32 v2, s41, v2
  v_lshlrev_b32 v3, 11, v2
  v_add_u32 v3, s40, v3
  v_mul_u32_u24 v2, 10240, v2
  v_and_b32 v6, 7, v1
  v_add_u32 v7, 8, v6
  s_mov_b32 s72, 0
  s_mov_b32 s73, 16384
  s_mov_b32 s74, 32768
  s_mov_b32 s75, 49152
  v_lshrrev_b32 v8, 3, v1
  s_lshl_b32 s41, s3, 5
  v_add_u32 v8, s41, v8
  v_cmp_gt_u32 vcc, 226, v8
  s_mov_b64 s[54:55], vcc
  s_mov_b64 s[64:65], -1
  v_mov_b32 v88, 0
  v_mov_b32 v89, 0
  s_mov_b64 s[66:67], -1
  v_mov_b32 v90, 0
  v_mov_b32 v91, 0
  s_mov_b64 s[68:69], -1
  v_mov_b32 v92, 0
  v_mov_b32 v93, 0
  s_mov_b64 s[70:71], s[54:55]
  v_mov_b32 v94, 0
  v_mov_b32 v95, 0
  s_mov_b32 s83, 0
  s_waitcnt vmcnt(0)
G_h1:
  s_mov_b64 exec, s[64:65]
  s_cbranch_execz G_ha0
  buffer_load_dwordx2 v[88:89], v3, s[36:39], s72 offen sc1
G_ha0:
  s_mov_b64 exec, s[66:67]
  s_cbranch_execz G_ha1
  buffer_load_dwordx2 v[90:91], v3, s[36:39], s73 offen sc1
G_ha1:
  s_mov_b64 exec, s[68:69]
  s_cbranch_execz G_ha2
  buffer_load_dwordx2 v[92:93], v3, s[36:39], s74 offen sc1
G_ha2:
  s_mov_b64 exec, s[70:71]
  s_cbranch_execz G_ha3
  buffer_load_dwordx2 v[94:95], v3, s[36:39], s75 offen sc1
G_ha3:
  s_mov_b64 exec, -1
  s_waitcnt vmcnt(0)
  v_cmp_ne_u32 s[64:65], s82, v89
  v_cmp_ne_u32 s[66:67], s82, v91
  v_cmp_ne_u32 s[68:69], s82, v93
  v_cmp_ne_u32 s[70:71], s82, v95
  s_and_b64 s[70:71], s[70:71], s[54:55]
  s_or_b64 s[42:43], s[64:65], s[66:67]
  s_or_b64 s[78:79], s[68:69], s[70:71]
  s_or_b64 s[42:43], s[42:43], s[78:79]
  s_cmp_eq_u64 s[42:43], 0
  s_cbranch_scc1 G_h1done
  s_add_u32 s83, s83, 1
  s_cmp_lt_u32 s83, 16384
  s_cbranch_scc1 G_h1
  s_branch G_setovf2
G_h1done:
  v_and_b32 v96, 0xffff, v88
  v_lshrrev_b32 v100, 16, v88
  v_add_u32 v96, v96, v6
  v_lshl_add_u32 v96, v96, 4, v2
  v_cmp_lt_u32 s[64:65], v6, v100
  v_cmp_lt_u32 s[46:47], v7, v100
  v_mov_b32 v59, 0
  v_mov_b32 v75, 0
  v_and_b32 v97, 0xffff, v90
  v_lshrrev_b32 v101, 16, v90
  v_add_u32 v97, v97, v6
  v_lshl_add_u32 v97, v97, 4, v2
  v_cmp_lt_u32 s[66:67], v6, v101
  v_cmp_lt_u32 s[48:49], v7, v101
  v_add_u32 v97, 81920, v97
  v_mov_b32 v63, 0
  v_mov_b32 v79, 0
  v_and_b32 v98, 0xffff, v92
  v_lshrrev_b32 v102, 16, v92
  v_add_u32 v98, v98, v6
  v_lshl_add_u32 v98, v98, 4, v2
  v_cmp_lt_u32 s[68:69], v6, v102
  v_cmp_lt_u32 s[50:51], v7, v102
  v_add_u32 v98, 163840, v98
  v_mov_b32 v67, 0
  v_mov_b32 v83, 0
  v_and_b32 v99, 0xffff, v94
  v_lshrrev_b32 v103, 16, v94
  v_add_u32 v99, v99, v6
  v_lshl_add_u32 v99, v99, 4, v2
  v_cmp_lt_u32 s[70:71], v6, v103
  v_cmp_lt_u32 s[52:53], v7, v103
  v_add_u32 v99, 245760, v99
  v_mov_b32 v71, 0
  v_mov_b32 v87, 0
  s_mov_b32 s83, 0
G_poll:
  v_cmp_ne_u32 vcc, s82, v59
  s_and_b64 exec, vcc, s[64:65]
  s_cbranch_execz G_pa0
  buffer_load_dwordx4 v[56:59], v96, s[36:39], 0 offen sc1
G_pa0:
  s_mov_b64 exec, -1
  v_cmp_ne_u32 vcc, s82, v75
  s_and_b64 exec, vcc, s[46:47]
  s_cbranch_execz G_pb0
  buffer_load_dwordx4 v[72:75], v96, s[36:39], 0 offen offset:128 sc1
G_pb0:
  s_mov_b64 exec, -1
  v_cmp_ne_u32 vcc, s82, v63
  s_and_b64 exec, vcc, s[66:67]
  s_cbranch_execz G_pa1
  buffer_load_dwordx4 v[60:63], v97, s[36:39], 0 offen sc1
G_pa1:
  s_mov_b64 exec, -1
  v_cmp_ne_u32 vcc, s82, v79
  s_and_b64 exec, vcc, s[48:49]
  s_cbranch_execz G_pb1
  buffer_load_dwordx4 v[76:79], v97, s[36:39], 0 offen offset:128 sc1
G_pb1:
  s_mov_b64 exec, -1
  v_cmp_ne_u32 vcc, s82, v67
  s_and_b64 exec, vcc, s[68:69]
  s_cbranch_execz G_pa2
  buffer_load_dwordx4 v[64:67], v98, s[36:39], 0 offen sc1
G_pa2:
  s_mov_b64 exec, -1
  v_cmp_ne_u32 vcc, s82, v83
  s_and_b64 exec, vcc, s[50:51]
  s_cbranch_execz G_pb2
  buffer_load_dwordx4 v[80:83], v98, s[36:39], 0 offen offset:128 sc1
G_pb2:
  s_mov_b64 exec, -1
  v_cmp_ne_u32 vcc, s82, v71
  s_and_b64 exec, vcc, s[70:71]
  s_cbranch_execz G_pa3
  buffer_load_dwordx4 v[68:71], v99, s[36:39], 0 offen sc1
G_pa3:
  s_mov_b64 exec, -1
  v_cmp_ne_u32 vcc, s82, v87
  s_and_b64 exec, vcc, s[52:53]
  s_cbranch_execz G_pb3
  buffer_load_dwordx4 v[84:87], v99, s[36:39], 0 offen offset:128 sc1
G_pb3:
  s_mov_b64 exec, -1
  s_cmp_eq_u32 s83, 0
  s_cbranch_scc0 G_nh2
  v_mov_b32 v8, 144972
  s_mov_b64 exec, 1
  ds_add_u32 v8, v27
  s_mov_b64 exec, -1
G_nh2:
  s_mov_b64 s[42:43], 0
  s_waitcnt vmcnt(0)
  v_cmp_ne_u32 vcc, s82, v59
  s_and_b64 vcc, vcc, s[64:65]
  s_or_b64 s[42:43], s[42:43], vcc
  v_cmp_ne_u32 vcc, s82, v75
  s_and_b64 vcc, vcc, s[46:47]
  s_or_b64 s[42:43], s[42:43], vcc
  v_cmp_ne_u32 vcc, s82, v63
  s_and_b64 vcc, vcc, s[66:67]
  s_or_b64 s[42:43], s[42:43], vcc
  v_cmp_ne_u32 vcc, s82, v79
  s_and_b64 vcc, vcc, s[48:49]
  s_or_b64 s[42:43], s[42:43], vcc
  v_cmp_ne_u32 vcc, s82, v67
  s_and_b64 vcc, vcc, s[68:69]
  s_or_b64 s[42:43], s[42:43], vcc
  v_cmp_ne_u32 vcc, s82, v83
  s_and_b64 vcc, vcc, s[50:51]
  s_or_b64 s[42:43], s[42:43], vcc
  v_cmp_ne_u32 vcc, s82, v71
  s_and_b64 vcc, vcc, s[70:71]
  s_or_b64 s[42:43], s[42:43], vcc
  v_cmp_ne_u32 vcc, s82, v87
  s_and_b64 vcc, vcc, s[52:53]
  s_or_b64 s[42:43], s[42:43], vcc
  s_cmp_eq_u64 s[42:43], 0
  s_cbranch_scc1 G_polldone
  s_add_u32 s83, s83, 1
  s_cmp_lt_u32 s83, 16384
  s_cbranch_scc1 G_poll
  s_branch G_setovf2
G_polldone:
  v_max_u32 v2, v100, v101
  v_max3_u32 v2, v2, v102, v103
  v_mov_b32 v9, 144704
  v_mov_b32 v4, 1
  v_cmp_lt_u32 vcc, 8, v2
  s_cbranch_vccnz G_line1
G_line1_ret:
  v_and_b32 v108, 63, v57
  v_lshl_add_u32 v104, v108, 2, v9
  v_and_b32 v109, 63, v61
  v_lshl_add_u32 v105, v109, 2, v9
  v_and_b32 v110, 63, v65
  v_lshl_add_u32 v106, v110, 2, v9
  v_and_b32 v111, 63, v69
  v_lshl_add_u32 v107, v111, 2, v9
  s_mov_b64 exec, s[64:65]
  ds_add_rtn_u32 v104, v104, v4
  s_mov_b64 exec, s[66:67]
  ds_add_rtn_u32 v105, v105, v4
  s_mov_b64 exec, s[68:69]
  ds_add_rtn_u32 v106, v106, v4
  s_mov_b64 exec, s[70:71]
  ds_add_rtn_u32 v107, v107, v4
  s_mov_b64 exec, -1
  v_and_b32 v57, 0xfffc00, v57
  v_mul_u32_u24 v108, 768, v108
  v_mov_b32 v59, v57
  v_add_u32 v108, 113920, v108
  v_and_b32 v61, 0xfffc00, v61
  v_mul_u32_u24 v109, 768, v109
  v_mov_b32 v63, v61
  v_add_u32 v109, 113920, v109
  v_and_b32 v65, 0xfffc00, v65
  v_mul_u32_u24 v110, 768, v110
  v_mov_b32 v67, v65
  v_add_u32 v110, 113920, v110
  v_and_b32 v69, 0xfffc00, v69
  v_mul_u32_u24 v111, 768, v111
  v_mov_b32 v71, v69
  v_add_u32 v111, 113920, v111
  s_mov_b64 s[42:43], 0
  s_waitcnt lgkmcnt(0)
  v_cmp_gt_u32 vcc, 48, v104
  v_lshl_add_u32 v108, v104, 4, v108
  s_andn2_b64 s[78:79], s[64:65], vcc
  s_or_b64 s[42:43], s[42:43], s[78:79]
  s_and_b64 exec, s[64:65], vcc
  ds_write_b128 v108, v[56:59]
  s_mov_b64 exec, -1
  v_cmp_gt_u32 vcc, 48, v105
  v_lshl_add_u32 v109, v105, 4, v109
  s_andn2_b64 s[78:79], s[66:67], vcc
  s_or_b64 s[42:43], s[42:43], s[78:79]
  s_and_b64 exec, s[66:67], vcc
  ds_write_b128 v109, v[60:63]
  s_mov_b64 exec, -1
  v_cmp_gt_u32 vcc, 48, v106
  v_lshl_add_u32 v110, v106, 4, v110
  s_andn2_b64 s[78:79], s[68:69], vcc
  s_or_b64 s[42:43], s[42:43], s[78:79]
  s_and_b64 exec, s[68:69], vcc
  ds_write_b128 v110, v[64:67]
  s_mov_b64 exec, -1
  v_cmp_gt_u32 vcc, 48, v107
  v_lshl_add_u32 v111, v107, 4, v111
  s_andn2_b64 s[78:79], s[70:71], vcc
  s_or_b64 s[42:43], s[42:43], s[78:79]
  s_and_b64 exec, s[70:71], vcc
  ds_write_b128 v111, v[68:71]
  s_mov_b64 exec, -1

  s_cmp_eq_u64 s[42:43], 0
  s_cbranch_scc0 G_setovf2
G_noovf:
  v_lshlrev_b32 v4, 2, v1
  v_add_u32 v4, 144704, v4
  v_mov_b32 v6, 144992
  s_waitcnt lgkmcnt(0)
  s_barrier

  ds_read_b32 v5, v4
  ds_read_b32 v7, v6
  ds_read_u16_d16_hi v28, v26 offset:0
  ds_read_u16_d16_hi v29, v26 offset:8
  ds_read_u16_d16_hi v30, v26 offset:256
  ds_read_u16_d16_hi v31, v26 offset:264
  ds_read_u16_d16_hi v32, v26 offset:512
  ds_read_u16_d16_hi v33, v26 offset:520
  ds_read_u16_d16_hi v34, v26 offset:768
  ds_read_u16_d16_hi v35, v26 offset:776
  ds_read_u16_d16_hi v36, v26 offset:1024
  ds_read_u16_d16_hi v37, v26 offset:1032
  s_mov_b32 s56, 4
  s_mov_b32 s57, 0
  s_mov_b32 s58, s63
  s_waitcnt lgkmcnt(10)
  v_readfirstlane_b32 s40, v7
  v_add_u32 v5, 3, v5
  v_lshrrev_b32 v5, 2, v5
  v_max_u32 v5, 1, v5
  v_min_u32 v5, 12, v5
  s_cmp_lg_u32 s40, 0
  s_cbranch_scc1 G_slow

  v_med3_u32 v8, v5, 3, 6
  v_cmp_gt_u32 vcc, 40, v1
  v_mov_b32 v9, 63
  s_mov_b64 s[44:45], vcc
  v_cndmask_b32 v8, 0, v8, vcc
  v_cmp_eq_u32 s[64:65], 3, v8
  v_cmp_eq_u32 s[66:67], 4, v8
  v_cmp_eq_u32 s[68:69], 5, v8
  v_cmp_eq_u32 s[70:71], 6, v8
  s_bcnt1_i32_b64 s41, s[64:65]
  s_bcnt1_i32_b64 s42, s[66:67]
  s_bcnt1_i32_b64 s43, s[68:69]
  s_add_u32 s42, s42, s41
  s_add_u32 s43, s43, s42
  v_mbcnt_lo_u32_b32 v2, s64, 0
  v_mbcnt_hi_u32_b32 v2, s65, v2
  v_cndmask_b32 v9, v9, v2, s[64:65]
  v_mbcnt_lo_u32_b32 v2, s66, 0
  v_mbcnt_hi_u32_b32 v2, s67, v2
  v_add_u32 v2, s41, v2
  v_cndmask_b32 v9, v9, v2, s[66:67]
  v_mbcnt_lo_u32_b32 v2, s68, 0
  v_mbcnt_hi_u32_b32 v2, s69, v2
  v_add_u32 v2, s42, v2
  v_cndmask_b32 v9, v9, v2, s[68:69]
  v_mbcnt_lo_u32_b32 v2, s70, 0
  v_mbcnt_hi_u32_b32 v2, s71, v2
  v_add_u32 v2, s43, v2
  v_cndmask_b32 v9, v9, v2, s[70:71]
  v_bfe_u32 v2, v9, 3, 1
  v_mul_u32_u24 v2, 7, v2
  v_xor_b32 v9, v9, v2
  v_lshlrev_b32 v2, 2, v9
  v_add_u32 v2, 161664, v2
  s_mov_b64 exec, s[44:45]
  ds_write_b32 v2, v1
  s_mov_b64 exec, -1
  s_mov_b32 s40, s3
  v_cmp_eq_u32 vcc, s40, v9
  s_add_u32 s40, s40, 8
  s_ff1_i32_b64 s41, vcc
  v_readlane_b32 s42, v5, s41
  s_mov_b32 s62, s41
  s_mul_i32 s46, s41, 768
  s_add_u32 s46, s46, 113920
  s_nop 0
  s_mov_b32 s59, s42
  v_cmp_eq_u32 vcc, s40, v9
  s_add_u32 s40, s40, 8
  s_ff1_i32_b64 s41, vcc
  v_readlane_b32 s42, v5, s41
  s_lshl_b32 s41, s41, 6
  s_or_b32 s62, s62, s41
  s_nop 0
  s_lshl_b32 s42, s42, 4
  s_or_b32 s59, s59, s42
  v_cmp_eq_u32 vcc, s40, v9
  s_add_u32 s40, s40, 8
  s_ff1_i32_b64 s41, vcc
  v_readlane_b32 s42, v5, s41
  s_lshl_b32 s41, s41, 12
  s_or_b32 s62, s62, s41
  s_nop 0
  s_lshl_b32 s42, s42, 8
  s_or_b32 s59, s59, s42
  v_cmp_eq_u32 vcc, s40, v9
  s_add_u32 s40, s40, 8
  s_ff1_i32_b64 s41, vcc
  v_readlane_b32 s42, v5, s41
  s_lshl_b32 s41, s41, 18
  s_or_b32 s62, s62, s41
  s_nop 0
  s_lshl_b32 s42, s42, 12
  s_or_b32 s59, s59, s42
  v_cmp_eq_u32 vcc, s40, v9
  s_nop 0
  s_ff1_i32_b64 s41, vcc
  v_readlane_b32 s42, v5, s41
  s_lshl_b32 s41, s41, 24
  s_or_b32 s62, s62, s41
  s_nop 0
  s_lshl_b32 s42, s42, 16
  s_or_b32 s59, s59, s42
  s_lshr_b32 s50, s62, 6
  s_and_b32 s47, s59, 15
  s_sub_u32 s47, s47, 1
  s_lshr_b32 s48, s59, 4
  s_mov_b32 s49, 4
  s_mov_b32 s51, 0
  s_mov_b32 s52, 64
  s_mov_b32 s54, s47
  s_mov_b32 s55, s48

  v_add_u32 v24, s46, v15
  s_mov_b32 s64, s51
  ds_read_b64 v[40:41], v24
  s_add_u32 s46, s46, s52
  s_sub_u32 s47, s47, 1
  s_cbranch_scc1 ADV_p0
ADVR_p0:
  v_add_u32 v24, s46, v15
  s_mov_b32 s65, s51
  ds_read_b64 v[42:43], v24
  s_add_u32 s46, s46, s52
  s_sub_u32 s47, s47, 1
  s_cbranch_scc1 ADV_p1
ADVR_p1:
  v_add_u32 v24, s46, v15
  s_mov_b32 s66, s51
  ds_read_b64 v[44:45], v24
  s_add_u32 s46, s46, s52
  s_sub_u32 s47, s47, 1
  s_cbranch_scc1 ADV_p2
ADVR_p2:
  v_add_u32 v24, s46, v15
  s_mov_b32 s67, s51
  ds_read_b64 v[46:47], v24
  s_add_u32 s46, s46, s52
  s_sub_u32 s47, s47, 1
  s_cbranch_scc1 ADV_p3
ADVR_p3:
  v_add_u32 v24, s46, v15
  s_mov_b32 s53, s51
  ds_read_b64 v[12:13], v24
  s_add_u32 s46, s46, s52
  s_sub_u32 s47, s47, 1
  s_cbranch_scc1 ADV_p4
ADVR_p4:
  s_waitcnt lgkmcnt(4)
  v_add3_u32 v11, v41, v14, s64
  buffer_load_dwordx4 v[56:59], v11, s[28:31], 0 offen
  buffer_load_dwordx4 v[60:63], v11, s[28:31], 0 offen offset:256
  v_mov_b32 v2, v40
  s_waitcnt lgkmcnt(3)
  v_add3_u32 v11, v43, v14, s65
  buffer_load_dwordx4 v[64:67], v11, s[28:31], 0 offen
  buffer_load_dwordx4 v[68:71], v11, s[28:31], 0 offen offset:256
  v_mov_b32 v3, v42
  s_waitcnt lgkmcnt(2)
  v_add3_u32 v11, v45, v14, s66
  buffer_load_dwordx4 v[72:75], v11, s[28:31], 0 offen
  buffer_load_dwordx4 v[76:79], v11, s[28:31], 0 offen offset:256
  v_mov_b32 v4, v44
  s_waitcnt lgkmcnt(1)
  v_add3_u32 v11, v47, v14, s67
  buffer_load_dwordx4 v[80:83], v11, s[28:31], 0 offen
  buffer_load_dwordx4 v[84:87], v11, s[28:31], 0 offen offset:256
  v_mov_b32 v5, v46
  v_mov_b64 v[40:41], 0
  v_mov_b64 v[42:43], 0
  v_mov_b64 v[44:45], 0
  v_mov_b64 v[46:47], 0
  v_mov_b64 v[48:49], 0
  v_mov_b64 v[50:51], 0
  v_mov_b64 v[52:53], 0
  v_mov_b64 v[54:55], 0
G_L0:
  s_waitcnt vmcnt(6)
  v_perm_b32 v20, v2, v2, v16
  v_perm_b32 v21, v2, v2, v17
  s_mov_b32 s40, s53
  s_mov_b32 s53, s51
  v_mfma_f32_16x16x32_bf16 v[40:43], v[20:23], v[56:59], v[40:43]
  v_mfma_f32_16x16x32_bf16 v[44:47], v[18:21], v[56:59], v[44:47]
  v_mfma_f32_16x16x32_bf16 v[48:51], v[20:23], v[60:63], v[48:51]
  v_mfma_f32_16x16x32_bf16 v[52:55], v[18:21], v[60:63], v[52:55]
  v_add_u32 v24, s46, v15
  s_waitcnt lgkmcnt(0)
  v_mov_b32 v2, v12
  v_add3_u32 v11, v13, v14, s40
  buffer_load_dwordx4 v[56:59], v11, s[28:31], 0 offen
  buffer_load_dwordx4 v[60:63], v11, s[28:31], 0 offen offset:256
  ds_read_b64 v[12:13], v24
  s_add_u32 s46, s46, s52
  s_sub_u32 s47, s47, 1
  s_cbranch_scc1 ADV_m0
ADVR_m0:
  s_sub_u32 s54, s54, 1
  s_cbranch_scc0 G_N0
  s_call_b64 s[60:61], G_flush
G_N0:
G_L1:
  s_waitcnt vmcnt(6)
  v_perm_b32 v20, v3, v3, v16
  v_perm_b32 v21, v3, v3, v17
  s_mov_b32 s40, s53
  s_mov_b32 s53, s51
  v_mfma_f32_16x16x32_bf16 v[40:43], v[20:23], v[64:67], v[40:43]
  v_mfma_f32_16x16x32_bf16 v[44:47], v[18:21], v[64:67], v[44:47]
  v_mfma_f32_16x16x32_bf16 v[48:51], v[20:23], v[68:71], v[48:51]
  v_mfma_f32_16x16x32_bf16 v[52:55], v[18:21], v[68:71], v[52:55]
  v_add_u32 v24, s46, v15
  s_waitcnt lgkmcnt(0)
  v_mov_b32 v3, v12
  v_add3_u32 v11, v13, v14, s40
  buffer_load_dwordx4 v[64:67], v11, s[28:31], 0 offen
  buffer_load_dwordx4 v[68:71], v11, s[28:31], 0 offen offset:256
  ds_read_b64 v[12:13], v24
  s_add_u32 s46, s46, s52
  s_sub_u32 s47, s47, 1
  s_cbranch_scc1 ADV_m1
ADVR_m1:
  s_sub_u32 s54, s54, 1
  s_cbranch_scc0 G_N1
  s_call_b64 s[60:61], G_flush
G_N1:
G_L2:
  s_waitcnt vmcnt(6)
  v_perm_b32 v20, v4, v4, v16
  v_perm_b32 v21, v4, v4, v17
  s_mov_b32 s40, s53
  s_mov_b32 s53, s51
  v_mfma_f32_16x16x32_bf16 v[40:43], v[20:23], v[72:75], v[40:43]
  v_mfma_f32_16x16x32_bf16 v[44:47], v[18:21], v[72:75], v[44:47]
  v_mfma_f32_16x16x32_bf16 v[48:51], v[20:23], v[76:79], v[48:51]
  v_mfma_f32_16x16x32_bf16 v[52:55], v[18:21], v[76:79], v[52:55]
  v_add_u32 v24, s46, v15
  s_waitcnt lgkmcnt(0)
  v_mov_b32 v4, v12
  v_add3_u32 v11, v13, v14, s40
  buffer_load_dwordx4 v[72:75], v11, s[28:31], 0 offen
  buffer_load_dwordx4 v[76:79], v11, s[28:31], 0 offen offset:256
  ds_read_b64 v[12:13], v24
  s_add_u32 s46, s46, s52
  s_sub_u32 s47, s47, 1
  s_cbranch_scc1 ADV_m2
ADVR_m2:
  s_sub_u32 s54, s54, 1
  s_cbranch_scc0 G_N2
  s_call_b64 s[60:61], G_flush
G_N2:
G_L3:
  s_waitcnt vmcnt(6)
  v_perm_b32 v20, v5, v5, v16
  v_perm_b32 v21, v5, v5, v17
  s_mov_b32 s40, s53
  s_mov_b32 s53, s51
  v_mfma_f32_16x16x32_bf16 v[40:43], v[20:23], v[80:83], v[40:43]
  v_mfma_f32_16x16x32_bf16 v[44:47], v[18:21], v[80:83], v[44:47]
  v_mfma_f32_16x16x32_bf16 v[48:51], v[20:23], v[84:87], v[48:51]
  v_mfma_f32_16x16x32_bf16 v[52:55], v[18:21], v[84:87], v[52:55]
  v_add_u32 v24, s46, v15
  s_waitcnt lgkmcnt(0)
  v_mov_b32 v5, v12
  v_add3_u32 v11, v13, v14, s40
  buffer_load_dwordx4 v[80:83], v11, s[28:31], 0 offen
  buffer_load_dwordx4 v[84:87], v11, s[28:31], 0 offen offset:256
  ds_read_b64 v[12:13], v24
  s_add_u32 s46, s46, s52
  s_sub_u32 s47, s47, 1
  s_cbranch_scc1 ADV_m3
ADVR_m3:
  s_sub_u32 s54, s54, 1
  s_cbranch_scc0 G_L0
  s_call_b64 s[60:61], G_flush
  s_branch G_L0
G_flush:
  v_add_u32 v26, s58, v25
  s_cmp_eq_u32 s57, 0
  s_cbranch_scc0 G_flushB
  ds_write_b32 v26, v49 offset:1280
  ds_write_b32 v26, v53 offset:1536
  v_xor_b32 v50, 0x80000000, v50
  v_xor_b32 v51, 0x80000000, v51
  v_xor_b32 v54, 0x80000000, v54
  v_xor_b32 v55, 0x80000000, v55
  v_mul_f32 v40, v40, v28
  v_mul_f32 v44, v44, v29
  v_mul_f32 v41, v41, v32
  v_mul_f32 v45, v45, v33
  v_mul_f32 v42, v42, v32
  v_mul_f32 v46, v46, v33
  v_mul_f32 v43, v43, v32
  v_mul_f32 v47, v47, v33
  v_mul_f32 v48, v48, v34
  v_mul_f32 v52, v52, v35
  ds_write_b32 v26, v50 offset:1792
  ds_write_b32 v26, v51 offset:2304
  ds_write_b32 v26, v54 offset:2048
  ds_write_b32 v26, v55 offset:2560
  v_cvt_pk_bf16_f32 v40, v40, v44
  v_cvt_pk_bf16_f32 v41, v41, v45
  v_cvt_pk_bf16_f32 v42, v42, v46
  v_cvt_pk_bf16_f32 v43, v43, v47
  v_cvt_pk_bf16_f32 v48, v48, v52
  ds_write_b32 v26, v40 offset:0
  ds_write_b32 v26, v41 offset:256
  ds_write_b32 v26, v42 offset:512
  ds_write_b32 v26, v43 offset:768
  ds_write_b32 v26, v48 offset:1024
  s_sub_u32 s40, 5, s56
  s_lshr_b32 s40, s40, 1
  s_lshl_b32 s40, s40, 2
  s_add_u32 s40, s40, 145012
  v_mov_b32 v38, s40
  s_mov_b64 exec, 1
  ds_add_u32 v38, v27
  s_mov_b64 exec, -1
  s_branch G_flushN
G_flushB:
  v_add_f32 v42, v42, v51
  v_sub_f32 v50, v50, v43
  v_add_f32 v46, v46, v55
  v_sub_f32 v54, v54, v47
  v_mul_f32 v40, v40, v34
  v_mul_f32 v44, v44, v35
  v_mul_f32 v48, v48, v34
  v_mul_f32 v52, v52, v35
  v_mul_f32 v49, -v49, v36
  v_mul_f32 v53, -v53, v37
  v_mul_f32 v41, v41, v36
  v_mul_f32 v45, v45, v37
  v_mul_f32 v42, v42, v30
  v_mul_f32 v46, v46, v31
  v_mul_f32 v50, v50, v36
  v_mul_f32 v54, v54, v37
  s_sub_u32 s40, 5, s56
  s_lshr_b32 s40, s40, 1
  s_lshl_b32 s40, s40, 2
  s_add_u32 s40, s40, 144960
  v_cvt_pk_bf16_f32 v40, v40, v44
  v_cvt_pk_bf16_f32 v48, v48, v52
  v_cvt_pk_bf16_f32 v49, v49, v53
  v_cvt_pk_bf16_f32 v41, v41, v45
  v_cvt_pk_bf16_f32 v42, v42, v46
  v_cvt_pk_bf16_f32 v50, v50, v54
  v_mov_b32 v38, s40
  ds_write_b32 v26, v40 offset:1536
  ds_write_b32 v26, v48 offset:1792
  ds_write_b32 v26, v49 offset:2304
  ds_write_b32 v26, v41 offset:2560
  ds_write_b32 v26, v42 offset:1280
  ds_write_b32 v26, v50 offset:2048
  s_mov_b64 exec, 1
  ds_add_u32 v38, v27
  s_mov_b64 exec, -1
G_flushN:
  s_add_u32 s58, s58, 22784
  s_sub_u32 s56, s56, 1
  s_cbranch_scc0 G_flushM
  s_cmp_eq_u32 s57, 0
  s_cbranch_scc0 G_done
  s_mov_b32 s57, 1
  s_mov_b32 s58, s63
  s_mov_b32 s55, s59
  s_mov_b32 s56, 4
G_flushM:
  s_and_b32 s54, s55, 15
  s_sub_u32 s54, s54, 1
  s_lshr_b32 s55, s55, 4
  v_mov_b64 v[40:41], 0
  v_mov_b64 v[42:43], 0
  v_mov_b64 v[44:45], 0
  v_mov_b64 v[46:47], 0
  v_mov_b64 v[48:49], 0
  v_mov_b64 v[50:51], 0
  v_mov_b64 v[52:53], 0
  v_mov_b64 v[54:55], 0
  s_cmp_eq_u32 s57, 0
  s_cbranch_scc1 G_flushR
  v_add_u32 v26, s58, v25
  ds_read_b32 v42, v26 offset:1280
  ds_read_b32 v41, v26 offset:1792
  ds_read_b32 v49, v26 offset:2304
  ds_read_b32 v46, v26 offset:1536
  ds_read_b32 v45, v26 offset:2048
  ds_read_b32 v53, v26 offset:2560
  s_waitcnt lgkmcnt(0)
G_flushR:
  s_setpc_b64 s[60:61]
G_done:
  s_endpgm
ADV_p0:
  s_sub_u32 s49, s49, 1
  s_cbranch_scc0 ADVN_p0
  s_cmp_eq_u32 s51, 0
  s_cbranch_scc0 ADVZ_p0
  s_mov_b32 s51, 512
  s_mov_b32 s50, s62
  s_mov_b32 s48, s59
  s_mov_b32 s49, 4
  s_barrier
ADVN_p0:
  s_and_b32 s46, s50, 63
  s_and_b32 s47, s48, 15
  s_mul_i32 s46, s46, 768
  s_lshr_b32 s50, s50, 6
  s_sub_u32 s47, s47, 1
  s_add_u32 s46, s46, 113920
  s_lshr_b32 s48, s48, 4
  s_branch ADVR_p0
ADVZ_p0:
  s_mov_b32 s46, 144640
  s_mov_b32 s52, 0
  s_mov_b32 s47, 0x7fffffff
  s_mov_b32 s49, 0x7fffffff
  s_branch ADVR_p0
ADV_p1:
  s_sub_u32 s49, s49, 1
  s_cbranch_scc0 ADVN_p1
  s_cmp_eq_u32 s51, 0
  s_cbranch_scc0 ADVZ_p1
  s_mov_b32 s51, 512
  s_mov_b32 s50, s62
  s_mov_b32 s48, s59
  s_mov_b32 s49, 4
  s_barrier
ADVN_p1:
  s_and_b32 s46, s50, 63
  s_and_b32 s47, s48, 15
  s_mul_i32 s46, s46, 768
  s_lshr_b32 s50, s50, 6
  s_sub_u32 s47, s47, 1
  s_add_u32 s46, s46, 113920
  s_lshr_b32 s48, s48, 4
  s_branch ADVR_p1
ADVZ_p1:
  s_mov_b32 s46, 144640
  s_mov_b32 s52, 0
  s_mov_b32 s47, 0x7fffffff
  s_mov_b32 s49, 0x7fffffff
  s_branch ADVR_p1
ADV_p2:
  s_sub_u32 s49, s49, 1
  s_cbranch_scc0 ADVN_p2
  s_cmp_eq_u32 s51, 0
  s_cbranch_scc0 ADVZ_p2
  s_mov_b32 s51, 512
  s_mov_b32 s50, s62
  s_mov_b32 s48, s59
  s_mov_b32 s49, 4
  s_barrier
ADVN_p2:
  s_and_b32 s46, s50, 63
  s_and_b32 s47, s48, 15
  s_mul_i32 s46, s46, 768
  s_lshr_b32 s50, s50, 6
  s_sub_u32 s47, s47, 1
  s_add_u32 s46, s46, 113920
  s_lshr_b32 s48, s48, 4
  s_branch ADVR_p2
ADVZ_p2:
  s_mov_b32 s46, 144640
  s_mov_b32 s52, 0
  s_mov_b32 s47, 0x7fffffff
  s_mov_b32 s49, 0x7fffffff
  s_branch ADVR_p2
ADV_p3:
  s_sub_u32 s49, s49, 1
  s_cbranch_scc0 ADVN_p3
  s_cmp_eq_u32 s51, 0
  s_cbranch_scc0 ADVZ_p3
  s_mov_b32 s51, 512
  s_mov_b32 s50, s62
  s_mov_b32 s48, s59
  s_mov_b32 s49, 4
  s_barrier
ADVN_p3:
  s_and_b32 s46, s50, 63
  s_and_b32 s47, s48, 15
  s_mul_i32 s46, s46, 768
  s_lshr_b32 s50, s50, 6
  s_sub_u32 s47, s47, 1
  s_add_u32 s46, s46, 113920
  s_lshr_b32 s48, s48, 4
  s_branch ADVR_p3
ADVZ_p3:
  s_mov_b32 s46, 144640
  s_mov_b32 s52, 0
  s_mov_b32 s47, 0x7fffffff
  s_mov_b32 s49, 0x7fffffff
  s_branch ADVR_p3
ADV_p4:
  s_sub_u32 s49, s49, 1
  s_cbranch_scc0 ADVN_p4
  s_cmp_eq_u32 s51, 0
  s_cbranch_scc0 ADVZ_p4
  s_mov_b32 s51, 512
  s_mov_b32 s50, s62
  s_mov_b32 s48, s59
  s_mov_b32 s49, 4
  s_barrier
ADVN_p4:
  s_and_b32 s46, s50, 63
  s_and_b32 s47, s48, 15
  s_mul_i32 s46, s46, 768
  s_lshr_b32 s50, s50, 6
  s_sub_u32 s47, s47, 1
  s_add_u32 s46, s46, 113920
  s_lshr_b32 s48, s48, 4
  s_branch ADVR_p4
ADVZ_p4:
  s_mov_b32 s46, 144640
  s_mov_b32 s52, 0
  s_mov_b32 s47, 0x7fffffff
  s_mov_b32 s49, 0x7fffffff
  s_branch ADVR_p4
ADV_m0:
  s_sub_u32 s49, s49, 1
  s_cbranch_scc0 ADVN_m0
  s_cmp_eq_u32 s51, 0
  s_cbranch_scc0 ADVZ_m0
  s_mov_b32 s51, 512
  s_mov_b32 s50, s62
  s_mov_b32 s48, s59
  s_mov_b32 s49, 4
  s_barrier
ADVN_m0:
  s_and_b32 s46, s50, 63
  s_and_b32 s47, s48, 15
  s_mul_i32 s46, s46, 768
  s_lshr_b32 s50, s50, 6
  s_sub_u32 s47, s47, 1
  s_add_u32 s46, s46, 113920
  s_lshr_b32 s48, s48, 4
  s_branch ADVR_m0
ADVZ_m0:
  s_mov_b32 s46, 144640
  s_mov_b32 s52, 0
  s_mov_b32 s47, 0x7fffffff
  s_mov_b32 s49, 0x7fffffff
  s_branch ADVR_m0
ADV_m1:
  s_sub_u32 s49, s49, 1
  s_cbranch_scc0 ADVN_m1
  s_cmp_eq_u32 s51, 0
  s_cbranch_scc0 ADVZ_m1
  s_mov_b32 s51, 512
  s_mov_b32 s50, s62
  s_mov_b32 s48, s59
  s_mov_b32 s49, 4
  s_barrier
ADVN_m1:
  s_and_b32 s46, s50, 63
  s_and_b32 s47, s48, 15
  s_mul_i32 s46, s46, 768
  s_lshr_b32 s50, s50, 6
  s_sub_u32 s47, s47, 1
  s_add_u32 s46, s46, 113920
  s_lshr_b32 s48, s48, 4
  s_branch ADVR_m1
ADVZ_m1:
  s_mov_b32 s46, 144640
  s_mov_b32 s52, 0
  s_mov_b32 s47, 0x7fffffff
  s_mov_b32 s49, 0x7fffffff
  s_branch ADVR_m1
ADV_m2:
  s_sub_u32 s49, s49, 1
  s_cbranch_scc0 ADVN_m2
  s_cmp_eq_u32 s51, 0
  s_cbranch_scc0 ADVZ_m2
  s_mov_b32 s51, 512
  s_mov_b32 s50, s62
  s_mov_b32 s48, s59
  s_mov_b32 s49, 4
  s_barrier
ADVN_m2:
  s_and_b32 s46, s50, 63
  s_and_b32 s47, s48, 15
  s_mul_i32 s46, s46, 768
  s_lshr_b32 s50, s50, 6
  s_sub_u32 s47, s47, 1
  s_add_u32 s46, s46, 113920
  s_lshr_b32 s48, s48, 4
  s_branch ADVR_m2
ADVZ_m2:
  s_mov_b32 s46, 144640
  s_mov_b32 s52, 0
  s_mov_b32 s47, 0x7fffffff
  s_mov_b32 s49, 0x7fffffff
  s_branch ADVR_m2
ADV_m3:
  s_sub_u32 s49, s49, 1
  s_cbranch_scc0 ADVN_m3
  s_cmp_eq_u32 s51, 0
  s_cbranch_scc0 ADVZ_m3
  s_mov_b32 s51, 512
  s_mov_b32 s50, s62
  s_mov_b32 s48, s59
  s_mov_b32 s49, 4
  s_barrier
ADVN_m3:
  s_and_b32 s46, s50, 63
  s_and_b32 s47, s48, 15
  s_mul_i32 s46, s46, 768
  s_lshr_b32 s50, s50, 6
  s_sub_u32 s47, s47, 1
  s_add_u32 s46, s46, 113920
  s_lshr_b32 s48, s48, 4
  s_branch ADVR_m3
ADVZ_m3:
  s_mov_b32 s46, 144640
  s_mov_b32 s52, 0
  s_mov_b32 s47, 0x7fffffff
  s_mov_b32 s49, 0x7fffffff
  s_branch ADVR_m3
G_setovf2:
  s_mov_b64 exec, -1
  v_mov_b32 v4, 144992
  v_mov_b32 v5, 1
  ds_write_b32 v4, v5
  v_mov_b32 v4, 144972
  s_mov_b64 exec, 1
  ds_add_u32 v4, v5
  s_mov_b64 exec, -1
  s_branch G_noovf
G_line1:
  v_cmp_lt_u32 vcc, 16, v2
  s_cbranch_vccz G_l1ok
  v_mov_b32 v5, 144992
  ds_write_b32 v5, v4
G_l1ok:
  v_and_b32 v108, 63, v73
  v_lshl_add_u32 v104, v108, 2, v9
  v_and_b32 v109, 63, v77
  v_lshl_add_u32 v105, v109, 2, v9
  v_and_b32 v110, 63, v81
  v_lshl_add_u32 v106, v110, 2, v9
  v_and_b32 v111, 63, v85
  v_lshl_add_u32 v107, v111, 2, v9
  s_mov_b64 exec, s[46:47]
  ds_add_rtn_u32 v104, v104, v4
  s_mov_b64 exec, s[48:49]
  ds_add_rtn_u32 v105, v105, v4
  s_mov_b64 exec, s[50:51]
  ds_add_rtn_u32 v106, v106, v4
  s_mov_b64 exec, s[52:53]
  ds_add_rtn_u32 v107, v107, v4
  s_mov_b64 exec, -1
  v_and_b32 v73, 0xfffc00, v73
  v_mul_u32_u24 v108, 768, v108
  v_mov_b32 v75, v73
  v_add_u32 v108, 113920, v108
  v_and_b32 v77, 0xfffc00, v77
  v_mul_u32_u24 v109, 768, v109
  v_mov_b32 v79, v77
  v_add_u32 v109, 113920, v109
  v_and_b32 v81, 0xfffc00, v81
  v_mul_u32_u24 v110, 768, v110
  v_mov_b32 v83, v81
  v_add_u32 v110, 113920, v110
  v_and_b32 v85, 0xfffc00, v85
  v_mul_u32_u24 v111, 768, v111
  v_mov_b32 v87, v85
  v_add_u32 v111, 113920, v111
  s_mov_b64 s[42:43], 0
  s_waitcnt lgkmcnt(0)
  v_cmp_gt_u32 vcc, 48, v104
  v_lshl_add_u32 v108, v104, 4, v108
  s_andn2_b64 s[78:79], s[46:47], vcc
  s_or_b64 s[42:43], s[42:43], s[78:79]
  s_and_b64 exec, s[46:47], vcc
  ds_write_b128 v108, v[72:75]
  s_mov_b64 exec, -1
  v_cmp_gt_u32 vcc, 48, v105
  v_lshl_add_u32 v109, v105, 4, v109
  s_andn2_b64 s[78:79], s[48:49], vcc
  s_or_b64 s[42:43], s[42:43], s[78:79]
  s_and_b64 exec, s[48:49], vcc
  ds_write_b128 v109, v[76:79]
  s_mov_b64 exec, -1
  v_cmp_gt_u32 vcc, 48, v106
  v_lshl_add_u32 v110, v106, 4, v110
  s_andn2_b64 s[78:79], s[50:51], vcc
  s_or_b64 s[42:43], s[42:43], s[78:79]
  s_and_b64 exec, s[50:51], vcc
  ds_write_b128 v110, v[80:83]
  s_mov_b64 exec, -1
  v_cmp_gt_u32 vcc, 48, v107
  v_lshl_add_u32 v111, v107, 4, v111
  s_andn2_b64 s[78:79], s[52:53], vcc
  s_or_b64 s[42:43], s[42:43], s[78:79]
  s_and_b64 exec, s[52:53], vcc
  ds_write_b128 v111, v[84:87]
  s_mov_b64 exec, -1
  s_cmp_eq_u64 s[42:43], 0
  s_cbranch_scc1 G_line1_ret
  v_mov_b32 v5, 144992
  ds_write_b32 v5, v4
  s_branch G_line1_ret

G_slow:
  s_waitcnt vmcnt(0)
  v_mov_b64 v[40:41], 0
  v_mov_b64 v[42:43], 0
  v_mov_b64 v[44:45], 0
  v_mov_b64 v[46:47], 0
  v_mov_b64 v[48:49], 0
  v_mov_b64 v[50:51], 0
  v_mov_b64 v[52:53], 0
  v_mov_b64 v[54:55], 0
  s_barrier
GS_node:
  s_sub_u32 s40, 4, s56
  s_lshl_b32 s40, s40, 3
  s_add_u32 s40, s40, s3
  s_cmp_ge_u32 s40, s81
  s_cbranch_scc1 GS_flush
  s_add_u32 s46, s40, s80
  s_lshl_b32 s51, s57, 9
  s_mov_b32 s47, 0
GS_chunk:
  v_add_u32 v2, s47, v1
  v_lshlrev_b32 v3, 2, v2
  global_load_dword v4, v3, s[12:13]
  s_waitcnt vmcnt(0)
  v_cmp_eq_u32 vcc, s46, v4
  s_cbranch_vccz GS_next
  s_mov_b64 s[64:65], vcc
  s_mov_b64 exec, vcc
  v_lshlrev_b32 v5, 1, v2
  v_mul_u32_u24 v6, 6, v2
  v_mov_b32 v58, 0
  v_mov_b32 v59, 0
  v_mov_b32 v60, 0
  v_mov_b32 v61, 0
  global_load_dword v57, v3, s[10:11]
  global_load_short_d16_hi v58, v5, s[8:9]
  global_load_short_d16_hi v59, v6, s[6:7]
  global_load_short_d16_hi v60, v6, s[6:7] offset:2
  global_load_short_d16_hi v61, v6, s[6:7] offset:4
  s_waitcnt vmcnt(0)
  v_mul_f32 v59, v58, v59
  v_mul_f32 v60, v58, v60
  v_mul_f32 v61, v58, v61
  v_cvt_pk_bf16_f32 v62, v58, v59
  v_cvt_pk_bf16_f32 v63, v60, v61
  v_lshlrev_b32 v57, 10, v57
  s_mov_b64 exec, -1
GS_edge:
  s_ff1_i32_b64 s40, s[64:65]
  s_bitset0_b64 s[64:65], s40
  v_readlane_b32 s41, v62, s40
  v_readlane_b32 s42, v63, s40
  v_readlane_b32 s43, v57, s40
  v_and_b32 v5, 2, v1
  v_cmp_eq_u32 vcc, 0, v5
  v_mov_b32 v5, s41
  v_mov_b32 v6, s42
  s_add_u32 s43, s43, s51
  v_cndmask_b32 v5, v6, v5, vcc
  v_cmp_gt_u32 vcc, 16, v1
  v_add_u32 v11, s43, v14
  v_mov_b32 v6, 2147418112
  v_mov_b32 v12, 0
  v_cndmask_b32 v11, v6, v11, vcc
  v_cndmask_b32 v12, v12, v5, vcc
  buffer_load_dwordx4 v[64:67], v11, s[28:31], 0 offen
  buffer_load_dwordx4 v[68:71], v11, s[28:31], 0 offen offset:256
  v_perm_b32 v20, v12, v12, v16
  v_perm_b32 v21, v12, v12, v17
  s_waitcnt vmcnt(0)
  s_nop 1
  v_mfma_f32_16x16x32_bf16 v[40:43], v[20:23], v[64:67], v[40:43]
  v_mfma_f32_16x16x32_bf16 v[44:47], v[18:21], v[64:67], v[44:47]
  v_mfma_f32_16x16x32_bf16 v[48:51], v[20:23], v[68:71], v[48:51]
  v_mfma_f32_16x16x32_bf16 v[52:55], v[18:21], v[68:71], v[52:55]
  s_cmp_lg_u64 s[64:65], 0
  s_cbranch_scc1 GS_edge
GS_next:
  s_add_u32 s47, s47, 64
  s_cmp_lt_u32 s47, 160000
  s_cbranch_scc1 GS_chunk
GS_flush:
  s_waitcnt lgkmcnt(0)
  s_nop 7
  s_call_b64 s[60:61], G_flush
  s_waitcnt lgkmcnt(0)
  s_branch GS_node

M_proj:
  s_cmp_eq_u32 s3, 8
  s_cbranch_scc0 PW_nopf
  s_lshr_b32 s40, s2, 3
  s_mul_i32 s40, s40, 40
  v_add_u32 v2, s40, v1
  v_cmp_gt_u32 vcc, 40, v1
  s_mov_b64 s[78:79], vcc
  v_cmp_gt_u32 vcc, 512, v2
  v_lshlrev_b32 v3, 7, v2
  s_and_b64 exec, vcc, s[78:79]
  s_cbranch_execz PW_pf1
  global_load_dword v13, v3, s[16:17]
PW_pf1:
  s_andn2_b64 exec, s[78:79], vcc
  s_cbranch_execz PW_pf2
  v_subrev_u32 v3, 65536, v3
  global_load_dword v13, v3, s[18:19]
PW_pf2:
  s_mov_b64 exec, -1
PW_nopf:

  s_barrier
  s_sub_u32 s47, s3, 8
  v_lshrrev_b32 v5, 4, v1
  v_and_b32 v8, 15, v1
  s_lshl_b32 s41, s47, 4
  v_add_u32 v2, s41, v5
  v_lshlrev_b32 v3, 8, v2
  v_lshl_add_u32 v3, v8, 4, v3
  v_add_u32 v4, 32768, v3
  v_add_u32 v6, 65536, v3
  v_mov_b32 v16, v3
  v_mov_b32 v17, v4
  v_mov_b32 v18, v6
  global_load_dwordx4 v[48:51], v16, s[16:17] offset:0
  global_load_dwordx4 v[52:55], v16, s[16:17] offset:1024
  global_load_dwordx4 v[56:59], v16, s[16:17] offset:2048
  global_load_dwordx4 v[60:63], v16, s[16:17] offset:3072

  v_mul_u32_u24 v3, 272, v2
  v_lshl_add_u32 v3, v8, 4, v3
  s_lshr_b32 s41, s47, 1
  s_lshl_b32 s41, s41, 5
  v_add_u32 v3, s41, v3
  v_add_u32 v4, 69888, v3
  v_lshlrev_b32 v6, 5, v5
  v_bfe_u32 v7, v1, 2, 2
  v_lshl_add_u32 v7, v7, 2, v6
  v_mul_u32_u24 v7, 272, v7
  v_add_u32 v7, v7, v6
  v_and_b32 v6, 3, v1
  v_lshl_add_u32 v7, v6, 3, v7
  s_lshl_b32 s41, s47, 5
  v_add_u32 v7, s41, v7
  v_add_u32 v6, 69888, v7
  v_mov_b32 v14, 144996
  v_mov_b32 v15, 1
  s_waitcnt vmcnt(3)
  ds_write_b128 v3, v[48:51] offset:0
  global_load_dwordx4 v[64:67], v17, s[16:17] offset:0
  s_waitcnt vmcnt(3)
  ds_write_b128 v3, v[52:55] offset:1088
  global_load_dwordx4 v[68:71], v17, s[16:17] offset:1024
  s_waitcnt vmcnt(3)
  ds_write_b128 v3, v[56:59] offset:2176
  global_load_dwordx4 v[72:75], v17, s[16:17] offset:2048
  s_waitcnt vmcnt(3)
  ds_write_b128 v3, v[60:63] offset:3264
  global_load_dwordx4 v[76:79], v17, s[16:17] offset:3072
  s_waitcnt vmcnt(3)
  ds_write_b128 v3, v[64:67] offset:34944
  global_load_dwordx4 v[80:83], v16, s[18:19] offset:0
  s_waitcnt vmcnt(3)
  ds_write_b128 v3, v[68:71] offset:36032
  global_load_dwordx4 v[84:87], v16, s[18:19] offset:1024
  s_waitcnt vmcnt(3)
  ds_write_b128 v3, v[72:75] offset:37120
  global_load_dwordx4 v[88:91], v16, s[18:19] offset:2048
  s_waitcnt vmcnt(3)
  ds_write_b128 v3, v[76:79] offset:38208
  global_load_dwordx4 v[92:95], v16, s[18:19] offset:3072
  s_waitcnt vmcnt(3)
  ds_write_b128 v4, v[80:83] offset:0
  global_load_dwordx4 v[96:99], v17, s[18:19] offset:0
  s_waitcnt vmcnt(3)
  ds_write_b128 v4, v[84:87] offset:1088
  global_load_dwordx4 v[100:103], v17, s[18:19] offset:1024
  s_waitcnt vmcnt(3)
  ds_write_b128 v4, v[88:91] offset:2176
  global_load_dwordx4 v[104:107], v17, s[18:19] offset:2048
  s_waitcnt vmcnt(3)
  ds_write_b128 v4, v[92:95] offset:3264
  global_load_dwordx4 v[108:111], v17, s[18:19] offset:3072
  s_waitcnt lgkmcnt(0)
  s_mov_b64 exec, 1
  ds_add_u32 v14, v15 offset:0
  s_mov_b64 exec, -1
PW_w1:
  ds_read_b32 v12, v14 offset:0
  s_waitcnt lgkmcnt(0)
  v_readfirstlane_b32 s41, v12
  s_nop 0
  s_cmp_lt_u32 s41, 8
  s_cbranch_scc1 PW_w1
  global_load_dwordx4 v[112:115], v18, s[18:19] offset:0
  global_load_dwordx4 v[116:119], v18, s[18:19] offset:1024
  global_load_dwordx4 v[120:123], v18, s[18:19] offset:2048
  global_load_dwordx4 v[124:127], v18, s[18:19] offset:3072
  ds_read_b64_tr_b16 v[48:49], v7 offset:0
  ds_read_b64_tr_b16 v[50:51], v7 offset:4352
  ds_read_b64_tr_b16 v[52:53], v7 offset:272
  ds_read_b64_tr_b16 v[54:55], v7 offset:4624
  ds_read_b64_tr_b16 v[56:57], v7 offset:544
  ds_read_b64_tr_b16 v[58:59], v7 offset:4896
  ds_read_b64_tr_b16 v[60:61], v7 offset:816
  ds_read_b64_tr_b16 v[62:63], v7 offset:5168
  ds_read_b64_tr_b16 v[64:65], v7 offset:34944
  ds_read_b64_tr_b16 v[66:67], v7 offset:39296
  ds_read_b64_tr_b16 v[68:69], v7 offset:35216
  ds_read_b64_tr_b16 v[70:71], v7 offset:39568
  ds_read_b64_tr_b16 v[72:73], v7 offset:35488
  ds_read_b64_tr_b16 v[74:75], v7 offset:39840
  ds_read_b64_tr_b16 v[76:77], v7 offset:35760
  ds_read_b64_tr_b16 v[78:79], v7 offset:40112
  ds_read_b64_tr_b16 v[80:81], v6 offset:0
  ds_read_b64_tr_b16 v[82:83], v6 offset:4352
  ds_read_b64_tr_b16 v[84:85], v6 offset:272
  ds_read_b64_tr_b16 v[86:87], v6 offset:4624
  ds_read_b64_tr_b16 v[88:89], v6 offset:544
  ds_read_b64_tr_b16 v[90:91], v6 offset:4896
  ds_read_b64_tr_b16 v[92:93], v6 offset:816
  ds_read_b64_tr_b16 v[94:95], v6 offset:5168
  s_waitcnt lgkmcnt(0)
  s_mov_b64 exec, 1
  ds_add_u32 v14, v15 offset:4
  s_mov_b64 exec, -1
PW_r1:
  ds_read_b32 v12, v14 offset:4
  s_waitcnt lgkmcnt(0)
  v_readfirstlane_b32 s41, v12
  s_nop 0
  s_cmp_lt_u32 s41, 8
  s_cbranch_scc1 PW_r1
  s_waitcnt vmcnt(7)
  ds_write_b128 v3, v[96:99] offset:0
  s_waitcnt vmcnt(6)
  ds_write_b128 v3, v[100:103] offset:1088
  s_waitcnt vmcnt(5)
  ds_write_b128 v3, v[104:107] offset:2176
  s_waitcnt vmcnt(4)
  ds_write_b128 v3, v[108:111] offset:3264
  s_waitcnt vmcnt(3)
  ds_write_b128 v3, v[112:115] offset:34944
  s_waitcnt vmcnt(2)
  ds_write_b128 v3, v[116:119] offset:36032
  s_waitcnt vmcnt(1)
  ds_write_b128 v3, v[120:123] offset:37120
  s_waitcnt vmcnt(0)
  ds_write_b128 v3, v[124:127] offset:38208
  s_waitcnt lgkmcnt(0)
  s_mov_b64 exec, 1
  ds_add_u32 v14, v15 offset:8
  s_mov_b64 exec, -1
PW_w2:
  ds_read_b32 v12, v14 offset:8
  s_waitcnt lgkmcnt(0)
  v_readfirstlane_b32 s41, v12
  s_nop 0
  s_cmp_lt_u32 s41, 8
  s_cbranch_scc1 PW_w2
  ds_read_b64_tr_b16 v[96:97], v7 offset:0
  ds_read_b64_tr_b16 v[98:99], v7 offset:4352
  ds_read_b64_tr_b16 v[100:101], v7 offset:272
  ds_read_b64_tr_b16 v[102:103], v7 offset:4624
  ds_read_b64_tr_b16 v[104:105], v7 offset:544
  ds_read_b64_tr_b16 v[106:107], v7 offset:4896
  ds_read_b64_tr_b16 v[108:109], v7 offset:816
  ds_read_b64_tr_b16 v[110:111], v7 offset:5168
  ds_read_b64_tr_b16 v[112:113], v7 offset:34944
  ds_read_b64_tr_b16 v[114:115], v7 offset:39296
  ds_read_b64_tr_b16 v[116:117], v7 offset:35216
  ds_read_b64_tr_b16 v[118:119], v7 offset:39568
  ds_read_b64_tr_b16 v[120:121], v7 offset:35488
  ds_read_b64_tr_b16 v[122:123], v7 offset:39840
  ds_read_b64_tr_b16 v[124:125], v7 offset:35760
  ds_read_b64_tr_b16 v[126:127], v7 offset:40112
  v_mov_b32 v14, 144972
PW_h2:
  ds_read_b32 v12, v14 offset:0
  s_waitcnt lgkmcnt(0)
  v_readfirstlane_b32 s41, v12
  s_nop 0
  s_cmp_lt_u32 s41, 8
  s_cbranch_scc1 PW_h2
  s_lshr_b32 s40, s2, 3
  s_mul_i32 s40, s40, 256
  s_mul_i32 s41, s47, 32
  s_add_u32 s40, s40, s41
  s_add_u32 s40, s40, 0
  v_add_u32 v20, s40, v1
  v_and_b32 v21, 3, v20
  v_lshrrev_b32 v20, 2, v20
  v_lshlrev_b32 v20, 10, v20
  v_lshl_add_u32 v20, v21, 7, v20
  s_bfm_b64 exec, 32, 0
  buffer_load_dword v13, v20, s[28:31], 0 offen
  s_mov_b64 exec, -1

  v_mul_u32_u24 v9, 2848, v8
  v_lshl_add_u32 v9, v5, 4, v9
  v_mul_u32_u24 v10, 1040, v8
  v_lshl_add_u32 v10, v5, 3, v10
  s_lshl_b32 s41, s47, 5
  s_add_u32 s41, s41, 145024
  v_add_u32 v3, s41, v10
  v_mov_b32 v2, v9
  s_mul_i32 s41, s47, 2080
  s_add_u32 s41, s41, 145024
  v_lshlrev_b32 v0, 4, v1
  v_add_u32 v1, s41, v0
  s_lshl_b32 s41, s47, 3
  s_add_u32 s41, s41, 161664
  v_mov_b32 v4, s41
  v_mov_b32 v5, 144960
  v_mov_b32 v6, 144976
  v_mov_b32 v7, 1
  s_waitcnt lgkmcnt(0)
  s_barrier
  s_barrier
  s_waitcnt vmcnt(0)
  s_mov_b32 s42, 0
PJ_tile:
  s_cmp_eq_u32 s42, 0
  s_cselect_b32 s43, 8, 16
PJ_pollA:
  ds_read_b32 v8, v5 offset:52
  s_waitcnt lgkmcnt(0)
  v_readfirstlane_b32 s41, v8
  s_nop 0
  s_cmp_lt_u32 s41, s43
  s_cbranch_scc1 PJ_pollA
  ds_read_b128 v[8:11], v2 offset:256
  ds_read_b128 v[12:15], v2 offset:512
  ds_read_b128 v[16:19], v2 offset:768
  ds_read_b128 v[20:23], v2 offset:0
  ds_read_b128 v[24:27], v2 offset:320
  ds_read_b128 v[28:31], v2 offset:576
  s_waitcnt lgkmcnt(5)
  v_mfma_f32_16x16x32_bf16 v[36:39], v[80:83], v[8:11], 0
  ds_read_b128 v[8:11], v2 offset:832
  s_waitcnt lgkmcnt(5)
  v_mfma_f32_16x16x32_bf16 v[40:43], v[80:83], v[12:15], 0
  ds_read_b128 v[12:15], v2 offset:64
  s_waitcnt lgkmcnt(5)
  v_mfma_f32_16x16x32_bf16 v[44:47], v[80:83], v[16:19], 0
  ds_read_b128 v[16:19], v2 offset:384
  s_waitcnt lgkmcnt(5)
  v_mfma_f32_16x16x32_bf16 v[32:35], v[48:51], v[20:23], 0
  ds_read_b128 v[20:23], v2 offset:640
  s_waitcnt lgkmcnt(5)
  v_mfma_f32_16x16x32_bf16 v[36:39], v[84:87], v[24:27], v[36:39]
  ds_read_b128 v[24:27], v2 offset:896
  s_waitcnt lgkmcnt(5)
  v_mfma_f32_16x16x32_bf16 v[40:43], v[84:87], v[28:31], v[40:43]
  ds_read_b128 v[28:31], v2 offset:128
  s_waitcnt lgkmcnt(5)
  v_mfma_f32_16x16x32_bf16 v[44:47], v[84:87], v[8:11], v[44:47]
  ds_read_b128 v[8:11], v2 offset:448
  s_waitcnt lgkmcnt(5)
  v_mfma_f32_16x16x32_bf16 v[32:35], v[52:55], v[12:15], v[32:35]
  ds_read_b128 v[12:15], v2 offset:704
  s_waitcnt lgkmcnt(5)
  v_mfma_f32_16x16x32_bf16 v[36:39], v[88:91], v[16:19], v[36:39]
  ds_read_b128 v[16:19], v2 offset:960
  s_waitcnt lgkmcnt(5)
  v_mfma_f32_16x16x32_bf16 v[40:43], v[88:91], v[20:23], v[40:43]
  ds_read_b128 v[20:23], v2 offset:192
  s_waitcnt lgkmcnt(5)
  v_mfma_f32_16x16x32_bf16 v[44:47], v[88:91], v[24:27], v[44:47]
  ds_read_b128 v[24:27], v2 offset:1024
  s_waitcnt lgkmcnt(5)
  v_mfma_f32_16x16x32_bf16 v[32:35], v[56:59], v[28:31], v[32:35]
  ds_read_b128 v[28:31], v2 offset:1088
  s_waitcnt lgkmcnt(5)
  v_mfma_f32_16x16x32_bf16 v[36:39], v[92:95], v[8:11], v[36:39]
  ds_read_b128 v[8:11], v2 offset:1152
  s_waitcnt lgkmcnt(5)
  v_mfma_f32_16x16x32_bf16 v[40:43], v[92:95], v[12:15], v[40:43]
  ds_read_b128 v[12:15], v2 offset:1216
  s_waitcnt lgkmcnt(5)
  v_mfma_f32_16x16x32_bf16 v[44:47], v[92:95], v[16:19], v[44:47]
  s_waitcnt lgkmcnt(4)
  v_mfma_f32_16x16x32_bf16 v[32:35], v[60:63], v[20:23], v[32:35]
  s_waitcnt lgkmcnt(3)
  v_mfma_f32_16x16x32_bf16 v[36:39], v[96:99], v[24:27], v[36:39]
  s_waitcnt lgkmcnt(2)
  v_mfma_f32_16x16x32_bf16 v[36:39], v[100:103], v[28:31], v[36:39]
  s_waitcnt lgkmcnt(1)
  v_mfma_f32_16x16x32_bf16 v[36:39], v[104:107], v[8:11], v[36:39]
  s_waitcnt lgkmcnt(0)
  v_mfma_f32_16x16x32_bf16 v[36:39], v[108:111], v[12:15], v[36:39]
  ds_read_b64 v[8:9], v4
  s_waitcnt lgkmcnt(0)
  v_readfirstlane_b32 s48, v8
  v_readfirstlane_b32 s49, v9
  s_cmp_eq_u32 s42, 0
  s_cselect_b32 s50, s47, 0
  s_cmp_ge_u32 s50, 4
  s_cselect_b32 s48, 63, s48
  s_cselect_b32 s49, 63, s49
  s_add_u32 s50, s48, s80
  s_add_u32 s51, s49, s80
  s_lshl_b32 s50, s50, 10
  s_lshl_b32 s51, s51, 10
  s_lshl_b32 s52, s42, 3
PJ_wb:
  ds_read_b32 v8, v6 offset:4
  s_waitcnt lgkmcnt(0)
  v_readfirstlane_b32 s41, v8
  s_nop 0
  s_cmp_lt_u32 s41, s52
  s_cbranch_scc1 PJ_wb
PJ_poll:
  ds_read_b32 v8, v5 offset:0
  s_waitcnt lgkmcnt(0)
  v_readfirstlane_b32 s41, v8
  s_nop 0
  s_cmp_lt_u32 s41, s43
  s_cbranch_scc1 PJ_poll
  ds_read_b128 v[8:11], v2 offset:2048
  ds_read_b128 v[12:15], v2 offset:1536
  ds_read_b128 v[16:19], v2 offset:1792
  ds_read_b128 v[20:23], v2 offset:1280
  ds_read_b128 v[24:27], v2 offset:2112
  ds_read_b128 v[28:31], v2 offset:1600
  s_waitcnt lgkmcnt(5)
  v_mfma_f32_16x16x32_bf16 v[36:39], v[112:115], v[8:11], v[36:39]
  ds_read_b128 v[8:11], v2 offset:1856
  s_waitcnt lgkmcnt(5)
  v_mfma_f32_16x16x32_bf16 v[40:43], v[96:99], v[12:15], v[40:43]
  ds_read_b128 v[12:15], v2 offset:1344
  s_waitcnt lgkmcnt(5)
  v_mfma_f32_16x16x32_bf16 v[44:47], v[96:99], v[16:19], v[44:47]
  ds_read_b128 v[16:19], v2 offset:2176
  s_waitcnt lgkmcnt(5)
  v_mfma_f32_16x16x32_bf16 v[32:35], v[64:67], v[20:23], v[32:35]
  ds_read_b128 v[20:23], v2 offset:1664
  s_waitcnt lgkmcnt(5)
  v_mfma_f32_16x16x32_bf16 v[36:39], v[116:119], v[24:27], v[36:39]
  ds_read_b128 v[24:27], v2 offset:1920
  s_waitcnt lgkmcnt(5)
  v_mfma_f32_16x16x32_bf16 v[40:43], v[100:103], v[28:31], v[40:43]
  ds_read_b128 v[28:31], v2 offset:1408
  s_waitcnt lgkmcnt(5)
  v_mfma_f32_16x16x32_bf16 v[44:47], v[100:103], v[8:11], v[44:47]
  ds_read_b128 v[8:11], v2 offset:2240
  s_waitcnt lgkmcnt(5)
  v_mfma_f32_16x16x32_bf16 v[32:35], v[68:71], v[12:15], v[32:35]
  ds_read_b128 v[12:15], v2 offset:1728
  s_waitcnt lgkmcnt(5)
  v_mfma_f32_16x16x32_bf16 v[36:39], v[120:123], v[16:19], v[36:39]
  ds_read_b128 v[16:19], v2 offset:1984
  s_waitcnt lgkmcnt(5)
  v_mfma_f32_16x16x32_bf16 v[40:43], v[104:107], v[20:23], v[40:43]
  ds_read_b128 v[20:23], v2 offset:1472
  s_waitcnt lgkmcnt(5)
  v_mfma_f32_16x16x32_bf16 v[44:47], v[104:107], v[24:27], v[44:47]
  ds_read_b128 v[24:27], v2 offset:2304
  s_waitcnt lgkmcnt(5)
  v_mfma_f32_16x16x32_bf16 v[32:35], v[72:75], v[28:31], v[32:35]
  ds_read_b128 v[28:31], v2 offset:2560
  s_waitcnt lgkmcnt(5)
  v_mfma_f32_16x16x32_bf16 v[36:39], v[124:127], v[8:11], v[36:39]
  ds_read_b128 v[8:11], v2 offset:2368
  s_waitcnt lgkmcnt(5)
  v_mfma_f32_16x16x32_bf16 v[40:43], v[108:111], v[12:15], v[40:43]
  ds_read_b128 v[12:15], v2 offset:2624
  s_waitcnt lgkmcnt(5)
  v_mfma_f32_16x16x32_bf16 v[44:47], v[108:111], v[16:19], v[44:47]
  ds_read_b128 v[16:19], v2 offset:2432
  s_waitcnt lgkmcnt(5)
  v_mfma_f32_16x16x32_bf16 v[32:35], v[76:79], v[20:23], v[32:35]
  ds_read_b128 v[20:23], v2 offset:2688
  s_waitcnt lgkmcnt(5)
  v_mfma_f32_16x16x32_bf16 v[40:43], v[112:115], v[24:27], v[40:43]
  ds_read_b128 v[24:27], v2 offset:2496
  s_waitcnt lgkmcnt(5)
  v_mfma_f32_16x16x32_bf16 v[44:47], v[112:115], v[28:31], v[44:47]
  ds_read_b128 v[28:31], v2 offset:2752
  s_waitcnt lgkmcnt(5)
  v_mfma_f32_16x16x32_bf16 v[40:43], v[116:119], v[8:11], v[40:43]
  s_waitcnt lgkmcnt(4)
  v_mfma_f32_16x16x32_bf16 v[44:47], v[116:119], v[12:15], v[44:47]
  s_waitcnt lgkmcnt(3)
  v_mfma_f32_16x16x32_bf16 v[40:43], v[120:123], v[16:19], v[40:43]
  s_waitcnt lgkmcnt(2)
  v_mfma_f32_16x16x32_bf16 v[44:47], v[120:123], v[20:23], v[44:47]
  s_waitcnt lgkmcnt(1)
  v_mfma_f32_16x16x32_bf16 v[40:43], v[124:127], v[24:27], v[40:43]
  s_waitcnt lgkmcnt(0)
  v_mfma_f32_16x16x32_bf16 v[44:47], v[124:127], v[28:31], v[44:47]
  s_nop 7
  s_mov_b32 s41, 0xbfb8aa3b
  v_mul_f32 v8, s41, v32
  v_mul_f32 v9, s41, v33
  v_mul_f32 v10, s41, v34
  v_mul_f32 v11, s41, v35
  v_exp_f32 v8, v8
  v_exp_f32 v9, v9
  v_exp_f32 v10, v10
  v_exp_f32 v11, v11
  v_cvt_pk_bf16_f32 v12, v32, v33
  v_add_f32 v8, 1.0, v8
  v_add_f32 v9, 1.0, v9
  v_add_f32 v10, 1.0, v10
  v_add_f32 v11, 1.0, v11
  v_rcp_f32 v8, v8
  v_rcp_f32 v9, v9
  v_rcp_f32 v10, v10
  v_rcp_f32 v11, v11
  v_cvt_pk_bf16_f32 v13, v34, v35
  v_mul_f32 v36, v36, v8
  v_mul_f32 v37, v37, v9
  v_mul_f32 v38, v38, v10
  v_mul_f32 v39, v39, v11
  v_mul_f32 v40, v40, v8
  v_mul_f32 v41, v41, v9
  v_mul_f32 v42, v42, v10
  v_mul_f32 v43, v43, v11
  v_mul_f32 v44, v44, v8
  v_mul_f32 v45, v45, v9
  v_mul_f32 v46, v46, v10
  v_mul_f32 v47, v47, v11
  v_cvt_pk_bf16_f32 v14, v36, v37
  v_cvt_pk_bf16_f32 v15, v38, v39
  v_cvt_pk_bf16_f32 v16, v40, v41
  v_cvt_pk_bf16_f32 v17, v42, v43
  v_cvt_pk_bf16_f32 v18, v44, v45
  v_cvt_pk_bf16_f32 v19, v46, v47
  s_lshl_b32 s43, s42, 3
  ds_write_b64 v3, v[12:13] offset:0
  ds_write_b64 v3, v[14:15] offset:256
  ds_write_b64 v3, v[16:17] offset:512
  ds_write_b64 v3, v[18:19] offset:768
  s_mov_b64 exec, 1
  ds_add_u32 v6, v7 offset:0
  s_mov_b64 exec, -1
  s_add_u32 s43, s43, 8
PJ_wa:
  ds_read_b32 v8, v6 offset:0
  s_waitcnt lgkmcnt(0)
  v_readfirstlane_b32 s41, v8
  s_nop 0
  s_cmp_lt_u32 s41, s43
  s_cbranch_scc1 PJ_wa
  ds_read_b128 v[8:11], v1
  ds_read_b128 v[12:15], v1 offset:1040
  s_cmp_lt_u32 s48, s81
  s_cbranch_scc0 PJ_ns0
  s_waitcnt lgkmcnt(1)
  buffer_store_dwordx4 v[8:11], v0, s[32:35], s50 offen sc1
PJ_ns0:
  s_cmp_lt_u32 s49, s81
  s_waitcnt lgkmcnt(0)
  s_cbranch_scc0 PJ_ns1
  buffer_store_dwordx4 v[12:15], v0, s[32:35], s51 offen sc1
PJ_ns1:
  s_mov_b64 exec, 1
  ds_add_u32 v6, v7 offset:4
  s_mov_b64 exec, -1
  s_cmp_eq_u32 s42, 0
  s_cselect_b32 s53, 32, 64
  s_mul_i32 s52, s53, 712
  v_add_u32 v2, s52, v2
  v_add_u32 v4, s53, v4
  v_add_u32 v5, 4, v5
  s_add_u32 s42, s42, 1
  s_cmp_lt_u32 s42, 3
  s_cbranch_scc1 PJ_tile
M_end:
  s_endpgm
M_last:

.section .rodata,"a"
.p2align 6
.amdhsa_kernel gather_scatter__tensor_product_equiv_equiformer__graph_kernel
  .amdhsa_next_free_vgpr 128
  .amdhsa_next_free_sgpr 102
  .amdhsa_accum_offset 128
  .amdhsa_group_segment_fixed_size 0
  .amdhsa_kernarg_size 96
  .amdhsa_user_sgpr_count 2
  .amdhsa_user_sgpr_kernarg_segment_ptr 1
  .amdhsa_system_sgpr_workgroup_id_x 1
  .amdhsa_float_denorm_mode_32 3
.end_amdhsa_kernel
.text
```
